```python
import torch

def _softmax(x, axis=-1):
    return torch.softmax(x, dim=axis)
def _gelu(x):
    return torch.nn.functional.gelu(x, approximate="tanh")
def _silu(x):
    return torch.nn.functional.silu(x)
def _sigmoid(x):
    return torch.sigmoid(x)
def _layernorm(x, axis=-1, eps=1e-5):
    m = x.mean(dim=axis, keepdim=True)
    v = x.var(dim=axis, keepdim=True, unbiased=False)
    return (x - m) / torch.sqrt(v + eps)
def _scatter_add(tgt, idx, src, axis=0):
    return tgt.clone().index_add_(axis, idx, src)
def _segment_sum(src, seg, n):
    out = torch.zeros((n,) + src.shape[1:], dtype=src.dtype)
    return out.index_add_(0, seg, src)
def _pad(x, pw):
    flat = tuple(v for pair in reversed(pw) for v in pair)
    return torch.nn.functional.pad(x, flat)

kernel_name = 'parallel_sum__sliding_block_cached__glu_gated_swiglu__decode'

def setup_inputs():

    _w = (lambda a: (lambda t: t.to(torch.bfloat16) if t.is_floating_point() else t)(torch.as_tensor(a)))
    def _A_setup():
        B, Sq, D = 1, 1, 512
        Hq, Hkv, Sk, Dh = 32, 8, 65536, 128
        assert Hq % Hkv == 0, (Hq, Hkv)
        return {
            "x": _w((lambda *s: torch.randn(*s, dtype=torch.bfloat16) * 0.05)(B, Sq, D)),
            "k_cache": _w((lambda *s: torch.randn(*s, dtype=torch.bfloat16) * 1.6)(B, Hkv, Sk, Dh)),
            "v_cache": _w((lambda *s: torch.randn(*s, dtype=torch.bfloat16) * 0.8)(B, Hkv, Sk, Dh)),
            "wq": _w((lambda *s: torch.randn(*s, dtype=torch.bfloat16) * 1.6)(D, Hq * Dh) * (D ** -0.5)),
            "wo": _w((lambda *s: torch.randn(*s, dtype=torch.bfloat16) * 0.8)(Hq * Dh, D) * ((Hq * Dh) ** -0.5)),
        }
    _A_in = _A_setup()

    def _B_setup():
        B, S, D, F = 1, 1, 512, 1792
        return {
            "x": _w((lambda *s: torch.randn(*s, dtype=torch.bfloat16) * 0.05)(B, S, D)),
            "w1": _w((lambda *s: torch.randn(*s, dtype=torch.bfloat16) * 0.4)(D, F) * (2.0 / D) ** 0.5),
            "w3": _w((lambda *s: torch.randn(*s, dtype=torch.bfloat16) * 0.4)(D, F) * (2.0 / D) ** 0.5),
            "w2": _w((lambda *s: torch.randn(*s, dtype=torch.bfloat16) * 0.4)(F, D) * (2.0 / F) ** 0.5),
        }
    _B_in = _B_setup()

    return {
        "A_x": _A_in["x"],
        "A_k_cache": _A_in["k_cache"],
        "A_v_cache": _A_in["v_cache"],
        "A_wq": _A_in["wq"],
        "A_wo": _A_in["wo"],
        "B_x": _B_in["x"],
        "B_w1": _B_in["w1"],
        "B_w3": _B_in["w3"],
        "B_w2": _B_in["w2"],
    }

def reference(A_x, A_k_cache, A_v_cache, A_wq, A_wo, B_x, B_w1, B_w3, B_w2):
    def _A_ref(x, k_cache, v_cache, wq, wo):
        B, Sq, D = x.shape
        Hq, Dh = 32, 128
        Hkv, Sk = k_cache.shape[1], k_cache.shape[2]
        W = min(4096, max(256, Sk // 4))
        rep = Hq // Hkv
        q = (lambda x, *d: x.permute(*d))((x @ wq).reshape(B, Sq, Hq, Dh), 0, 2, 1, 3)
        k = (lambda x, n, axis: torch.repeat_interleave(x, n, dim=axis))(k_cache[:, :, Sk - W:, :], rep, axis=1)
        v = (lambda x, n, axis: torch.repeat_interleave(x, n, dim=axis))(v_cache[:, :, Sk - W:, :], rep, axis=1)
        scores = torch.einsum("bhqd,bhkd->bhqk", q, k) * (Dh ** -0.5)
        p = _softmax(scores, axis=-1)
        o = torch.einsum("bhqk,bhkd->bhqd", p, v)
        return (lambda x, *d: x.permute(*d))(o, 0, 2, 1, 3).reshape(B, Sq, Hq * Dh) @ wo

    def _B_ref(x, w1, w3, w2):
        gate = torch.einsum("bsd,df->bsf", x, w1)
        up = torch.einsum("bsd,df->bsf", x, w3)
        h = _silu(gate) * up
        out = torch.einsum("bsf,fd->bsd", h, w2)
        return out

    x = A_x
    xn = _layernorm(x, axis=-1)
    return x + _A_ref(xn, A_k_cache, A_v_cache, A_wq, A_wo) + _B_ref(xn, B_w1, B_w3, B_w2)
```

```asm
; @launch grid=(256,1,1) block=(704,1,1) lds=131392
.amdgcn_target "amdgcn-amd-amdhsa--gfx950"
.text
.globl parallel_sum__sliding_block_cached__glu_gated_swiglu__decode_kernel
.p2align 10
.p2align 8
.type parallel_sum__sliding_block_cached__glu_gated_swiglu__decode_kernel,@function
parallel_sum__sliding_block_cached__glu_gated_swiglu__decode_kernel:
    s_load_dwordx16 s[4:19], s[0:1], 0
    s_load_dwordx8 s[20:27], s[0:1], 64
    s_getpc_b64 s[84:85]
L_pc:
    v_lshlrev_b32 v140, 7, v0
    v_min_u32 v140, L_end-L_pc, v140
    global_load_dword v140, v140, s[84:85]
    v_lshrrev_b32 v2, 6, v0
    v_and_b32 v1, 63, v0
    s_cmpk_ge_u32 s2, 256
    s_cbranch_scc1 L_end
    v_readfirstlane_b32 s30, v2
    s_and_b32 s28, s2, 7
    s_lshr_b32 s29, s2, 3
    v_lshlrev_b32 v3, 4, v1
    s_cmp_lg_u32 s30, 0
    s_cbranch_scc1 L_notloader
    s_setprio 3
    s_and_b32 s33, s29, 3
    s_lshr_b32 s34, s29, 2
    s_lshl_b32 s88, s33, 20
    s_lshl_b32 s33, s28, 10
    s_add_u32 s88, s88, s33
    s_lshl_b32 s34, s34, 7
    s_add_u32 s88, s88, s34
    v_lshrrev_b32 v28, 3, v1
    v_and_b32 v29, 7, v1
    v_lshlrev_b32 v29, 4, v29
    v_lshl_add_u32 v8, v28, 13, v29
    v_add_u32 v8, s88, v8
    v_add_u32 v9, 64512, v8
    v_add_u32 v10, 129024, v8
    v_add_u32 v11, 193536, v8
    v_mov_b32 v4, 0
    s_mov_b32 m0, 122880
    s_mov_b32 s31, 0
    s_mov_b32 s32, -20
    s_waitcnt lgkmcnt(0)
    global_load_lds_dwordx4 v3, s[4:5]
    s_mov_b32 m0, 130368
    s_mov_b32 s80, 0x40000
    global_load_lds_dword v4, s[26:27] sc1
L_seg_1:
    s_mov_b32 m0, s31
    s_add_u32 s31, s31, 4096
    global_load_lds_dwordx4 v8, s[10:11] offset:0 nt
    global_load_lds_dwordx4 v9, s[10:11] offset:1024 nt
    global_load_lds_dwordx4 v10, s[10:11] offset:2048 nt
    global_load_lds_dwordx4 v11, s[10:11] offset:3072 nt
    s_add_u32 s10, s10, s80
    s_addc_u32 s11, s11, 0
    s_add_i32 s32, s32, 4
    s_cmp_lt_u32 s31, 16384
    s_cbranch_scc1 L_seg_1
    s_branch L_loader2
L_notloader:
    s_cmp_eq_u32 s30, 1
    s_cbranch_scc1 L_sync0
    s_cmp_eq_u32 s30, 10
    s_cbranch_scc1 L_mlp
    s_branch L_compute
L_sync0:
    v_mov_b32 v2, 122880
    v_add_u32 v22, 122880, v3
    v_mov_b32 v8, 0
    v_mov_b32 v9, 0
    v_mov_b32 v10, 0
    v_mov_b32 v11, 0
    v_mov_b32 v12, 0x80000000
    s_mov_b64 exec, 15
    ds_write_b128 v22, v[8:11] offset:7424
    s_mov_b64 exec, 0xff
    ds_write_b128 v22, v[8:11] offset:8000
    s_mov_b64 exec, -1
    ds_write_b32 v2, v12 offset:8128
    s_waitcnt lgkmcnt(0)
    s_barrier
    s_branch L_sync
L_loader2:
    v_mov_b32 v2, 122880
    s_cmp_lt_u32 s29, 28
    s_cselect_b32 s95, 1, 0
    s_cselect_b32 s37, 0x7fffffff, 16
    s_mul_i32 s38, s28, 28
    s_add_u32 s38, s38, s29
    s_lshl_b32 s89, s28, 24
    s_lshl_b32 s33, s29, 15
    s_add_u32 s89, s89, s33
    s_add_u32 s89, s89, 0xF00000
    s_and_b32 s90, s28, 3
    s_mul_i32 s90, s90, 458752
    s_lshl_b32 s34, s29, 7
    s_add_u32 s90, s90, s34
    s_lshl_b32 s91, s28, 19
    s_lshl_b32 s34, s29, 12
    s_add_u32 s91, s91, s34
    v_mul_u32_u24 v12, 3584, v28
    v_add_u32 v12, v12, v29
    v_add_u32 v12, s90, v12
    v_add_u32 v13, 27648, v12
    v_add_u32 v14, 55296, v12
    v_add_u32 v15, 82944, v12
    v_lshl_add_u32 v22, v1, 2, v2
    s_cmp_ge_u32 s28, 4
    s_cselect_b32 s74, s18, s16
    s_cselect_b32 s75, s19, s17
    v_lshrrev_b32 v28, 4, v1
    v_and_b32 v29, 15, v1
    v_xor_b32 v16, v29, v28
    v_lshlrev_b32 v16, 4, v16
    v_lshl_add_u32 v16, v28, 8, v16
    v_add_u32 v16, s89, v16
    v_xor_b32 v17, 64, v16
    v_xor_b32 v18, 128, v16
    v_xor_b32 v19, 192, v16
    v_lshlrev_b32 v20, 1, v28
    v_xor_b32 v20, v29, v20
    v_lshlrev_b32 v20, 4, v20
    v_lshl_add_u32 v20, v28, 8, v20
    v_add_u32 v20, s89, v20
    v_xor_b32 v21, 128, v20
    v_add_u32 v24, s91, v3
    v_xor_b32 v25, 16, v24
    v_xor_b32 v26, 128, v24
    v_xor_b32 v27, 144, v24
    v_mov_b32 v30, v3
    v_xor_b32 v31, 16, v3
    v_xor_b32 v32, 128, v3
    v_xor_b32 v33, 144, v3
    s_lshl_b32 s34, s38, 13
    s_add_u32 s78, s20, s34
    s_addc_u32 s79, s21, 0
    s_mov_b32 s80, 114688
    v_mov_b32 v5, 1
    s_barrier
    s_waitcnt vmcnt(16)
    ds_write_b32 v2, v5 offset:8072
    s_cmp_eq_u32 s95, 0
    s_cbranch_scc1 L_ldnomlp_2
L_seg_3:
    s_mov_b32 m0, s31
    s_add_u32 s31, s31, 4096
    global_load_lds_dwordx4 v12, s[74:75] offset:0 nt
    s_waitcnt vmcnt(20)
    global_load_lds_dwordx4 v13, s[74:75] offset:1024 nt
    s_waitcnt vmcnt(20)
    global_load_lds_dwordx4 v14, s[74:75] offset:2048 nt
    s_waitcnt vmcnt(20)
    global_load_lds_dwordx4 v15, s[74:75] offset:3072 nt
    s_waitcnt vmcnt(20)
    s_add_u32 s74, s74, s80
    s_addc_u32 s75, s75, 0
    s_add_i32 s32, s32, 4
    v_mov_b32 v23, s32
    ds_write_b32 v22, v23 offset:8128
    s_cmp_lt_u32 s31, 32768
    s_cbranch_scc1 L_seg_3
L_ldnomlp_2:
    s_mov_b32 s31, 32768
L_seg_4:
    s_mov_b32 m0, s31
    s_add_u32 s31, s31, 4096
    global_load_lds_dwordx4 v16, s[6:7] offset:0 nt
    s_waitcnt vmcnt(20)
    global_load_lds_dwordx4 v17, s[6:7] offset:1024 nt
    s_waitcnt vmcnt(20)
    global_load_lds_dwordx4 v18, s[6:7] offset:2048 nt
    s_waitcnt vmcnt(20)
    global_load_lds_dwordx4 v19, s[6:7] offset:3072 nt
    s_waitcnt vmcnt(20)
    s_add_u32 s6, s6, 4096
    s_addc_u32 s7, s7, 0
    s_cmp_eq_i32 s32, s37
    s_cselect_b32 s33, 20, 4
    s_add_i32 s32, s32, s33
    v_mov_b32 v23, s32
    ds_write_b32 v22, v23 offset:8128
    s_cmp_lt_u32 s31, 65536
    s_cbranch_scc1 L_seg_4
L_seg_5:
    s_mov_b32 m0, s31
    s_add_u32 s31, s31, 4096
    global_load_lds_dwordx4 v20, s[8:9] offset:0 nt
    s_waitcnt vmcnt(20)
    global_load_lds_dwordx4 v20, s[8:9] offset:1024 nt
    s_waitcnt vmcnt(20)
    global_load_lds_dwordx4 v21, s[8:9] offset:2048 nt
    s_waitcnt vmcnt(20)
    global_load_lds_dwordx4 v21, s[8:9] offset:3072 nt
    s_waitcnt vmcnt(20)
    s_add_u32 s8, s8, 4096
    s_addc_u32 s9, s9, 0
    s_add_i32 s32, s32, 4
    v_mov_b32 v23, s32
    ds_write_b32 v22, v23 offset:8128
    s_cmp_lt_u32 s31, 98304
    s_cbranch_scc1 L_seg_5
L_seg_6:
    s_mov_b32 m0, s31
    s_add_u32 s31, s31, 4096
    global_load_lds_dwordx4 v24, s[12:13] offset:0 nt
    s_waitcnt vmcnt(20)
    global_load_lds_dwordx4 v25, s[12:13] offset:1024 nt
    s_waitcnt vmcnt(20)
    global_load_lds_dwordx4 v26, s[12:13] offset:2048 nt
    s_waitcnt vmcnt(20)
    global_load_lds_dwordx4 v27, s[12:13] offset:3072 nt
    s_waitcnt vmcnt(20)
    s_add_u32 s12, s12, 0x20000
    s_addc_u32 s13, s13, 0
    s_add_i32 s32, s32, 4
    v_mov_b32 v23, s32
    ds_write_b32 v22, v23 offset:8128
    s_cmp_lt_u32 s31, 114688
    s_cbranch_scc1 L_seg_6
    s_cmp_eq_u32 s95, 0
    s_cbranch_scc1 L_ldnomlp2_7
L_seg_8:
    s_mov_b32 m0, s31
    s_add_u32 s31, s31, 4096
    global_load_lds_dwordx4 v30, s[78:79] offset:0 nt
    s_waitcnt vmcnt(20)
    global_load_lds_dwordx4 v31, s[78:79] offset:1024 nt
    s_waitcnt vmcnt(20)
    global_load_lds_dwordx4 v32, s[78:79] offset:2048 nt
    s_waitcnt vmcnt(20)
    global_load_lds_dwordx4 v33, s[78:79] offset:3072 nt
    s_waitcnt vmcnt(20)
    s_add_u32 s78, s78, 4096
    s_addc_u32 s79, s79, 0
    s_add_i32 s32, s32, 4
    v_mov_b32 v23, s32
    ds_write_b32 v22, v23 offset:8128
    s_cmp_lt_u32 s31, 122880
    s_cbranch_scc1 L_seg_8
L_ldnomlp2_7:
    s_waitcnt vmcnt(16)
    s_add_i32 s32, s32, 4
    v_mov_b32 v23, s32
    ds_write_b32 v22, v23 offset:8128
    s_waitcnt vmcnt(12)
    s_add_i32 s32, s32, 4
    v_mov_b32 v23, s32
    ds_write_b32 v22, v23 offset:8128
    s_waitcnt vmcnt(8)
    s_add_i32 s32, s32, 4
    v_mov_b32 v23, s32
    ds_write_b32 v22, v23 offset:8128
    s_waitcnt vmcnt(4)
    s_add_i32 s32, s32, 4
    v_mov_b32 v23, s32
    ds_write_b32 v22, v23 offset:8128
    v_mov_b32 v23, 120
    s_waitcnt vmcnt(0)
    ds_write_b32 v22, v23 offset:8128
    s_mov_b32 s30, 9
    s_waitcnt lgkmcnt(0)
    s_branch L_fin
L_sync:
    s_setprio 2
    s_mov_b32 s30, 8
    s_mov_b32 s92, 0xffff0000
    s_mov_b32 s93, 0x3fb8aa3b
    s_mov_b32 s3, 0x01010101
    s_mov_b32 s96, 0x05030201
    s_mov_b32 s97, 0x06050302
    s_mov_b32 s98, 0x07060503
    s_mov_b32 s99, 0x0504030c
    s_mov_b32 s100, 0x0403020c
    s_mov_b32 s101, 0xffffff00
    s_mov_b32 s35, 1048576
L_xw_9:
    ds_read_b32 v28, v2 offset:8072
    ds_read_b128 v[72:75], v22 offset:0
    ds_read_b32 v25, v2 offset:7488
    s_waitcnt lgkmcnt(0)
    v_cmp_ne_u32 vcc, 1, v28
    s_cbranch_vccz L_xwd_10
    s_sub_u32 s35, s35, 1
    s_cmp_lg_u32 s35, 0
    s_cbranch_scc1 L_xw_9
L_xwd_10:
    v_lshlrev_b32 v76, 16, v72
    v_and_b32 v77, s92, v72
    v_lshlrev_b32 v78, 16, v73
    v_and_b32 v79, s92, v73
    v_lshlrev_b32 v80, 16, v74
    v_and_b32 v81, s92, v74
    v_lshlrev_b32 v82, 16, v75
    v_and_b32 v83, s92, v75
    v_add_f32 v84, v76, v77
    v_add_f32 v85, v78, v79
    v_add_f32 v86, v80, v81
    v_add_f32 v87, v82, v83
    v_add_f32 v84, v84, v85
    v_add_f32 v86, v86, v87
    v_add_f32 v84, v84, v86
    s_nop 1
    v_add_f32_dpp v84, v84, v84 row_shr:1 row_mask:0xf bank_mask:0xf
    s_nop 1
    v_add_f32_dpp v84, v84, v84 row_shr:2 row_mask:0xf bank_mask:0xf
    s_nop 1
    v_add_f32_dpp v84, v84, v84 row_shr:4 row_mask:0xf bank_mask:0xf
    s_nop 1
    v_add_f32_dpp v84, v84, v84 row_shr:8 row_mask:0xf bank_mask:0xf
    s_nop 1
    v_add_f32_dpp v84, v84, v84 row_bcast:15 row_mask:0xa bank_mask:0xf
    s_nop 1
    v_add_f32_dpp v84, v84, v84 row_bcast:31 row_mask:0xc bank_mask:0xf
    s_nop 1
    s_nop 0
    v_readlane_b32 s33, v84, 63
    s_nop 2
    v_mov_b32 v88, s33
    v_mul_f32 v88, 0x3b000000, v88
    v_sub_f32 v92, v76, v88
    v_sub_f32 v93, v77, v88
    v_sub_f32 v94, v78, v88
    v_sub_f32 v95, v79, v88
    v_sub_f32 v96, v80, v88
    v_sub_f32 v97, v81, v88
    v_sub_f32 v98, v82, v88
    v_sub_f32 v99, v83, v88
    v_mul_f32 v84, v92, v92
    v_fmac_f32 v84, v93, v93
    v_fmac_f32 v84, v94, v94
    v_fmac_f32 v84, v95, v95
    v_fmac_f32 v84, v96, v96
    v_fmac_f32 v84, v97, v97
    v_fmac_f32 v84, v98, v98
    v_fmac_f32 v84, v99, v99
    s_nop 1
    v_add_f32_dpp v84, v84, v84 row_shr:1 row_mask:0xf bank_mask:0xf
    s_nop 1
    v_add_f32_dpp v84, v84, v84 row_shr:2 row_mask:0xf bank_mask:0xf
    s_nop 1
    v_add_f32_dpp v84, v84, v84 row_shr:4 row_mask:0xf bank_mask:0xf
    s_nop 1
    v_add_f32_dpp v84, v84, v84 row_shr:8 row_mask:0xf bank_mask:0xf
    s_nop 1
    v_add_f32_dpp v84, v84, v84 row_bcast:15 row_mask:0xa bank_mask:0xf
    s_nop 1
    v_add_f32_dpp v84, v84, v84 row_bcast:31 row_mask:0xc bank_mask:0xf
    s_nop 1
    s_nop 0
    v_readlane_b32 s33, v84, 63
    s_nop 2
    v_mov_b32 v89, s33
    v_mul_f32 v89, 0x3b000000, v89
    v_cvt_pk_bf16_f32 v88, v88, v88
    v_lshlrev_b32 v88, 16, v88
    v_cvt_pk_bf16_f32 v89, v89, v89
    v_lshlrev_b32 v89, 16, v89
    v_add_f32 v89, 0x3727c5ac, v89
    v_cvt_pk_bf16_f32 v89, v89, v89
    v_lshlrev_b32 v89, 16, v89
    v_sqrt_f32 v89, v89
    s_nop 0
    v_cvt_pk_bf16_f32 v89, v89, v89
    v_lshlrev_b32 v89, 16, v89
    v_rcp_f32 v90, v89
    v_sub_f32 v76, v76, v88
    v_sub_f32 v77, v77, v88
    v_sub_f32 v78, v78, v88
    v_sub_f32 v79, v79, v88
    v_sub_f32 v80, v80, v88
    v_sub_f32 v81, v81, v88
    v_sub_f32 v82, v82, v88
    v_sub_f32 v83, v83, v88
    v_cvt_pk_bf16_f32 v92, v76, v77
    v_cvt_pk_bf16_f32 v93, v78, v79
    v_cvt_pk_bf16_f32 v94, v80, v81
    v_cvt_pk_bf16_f32 v95, v82, v83
    v_lshlrev_b32 v76, 16, v92
    v_and_b32 v77, s92, v92
    v_lshlrev_b32 v78, 16, v93
    v_and_b32 v79, s92, v93
    v_lshlrev_b32 v80, 16, v94
    v_and_b32 v81, s92, v94
    v_lshlrev_b32 v82, 16, v95
    v_and_b32 v83, s92, v95
    v_mul_f32 v92, v76, v90
    v_mul_f32 v93, v77, v90
    v_mul_f32 v94, v78, v90
    v_mul_f32 v95, v79, v90
    v_mul_f32 v96, v80, v90
    v_mul_f32 v97, v81, v90
    v_mul_f32 v98, v82, v90
    v_mul_f32 v99, v83, v90
    v_fma_f32 v76, -v92, v89, v76
    v_fma_f32 v77, -v93, v89, v77
    v_fma_f32 v78, -v94, v89, v78
    v_fma_f32 v79, -v95, v89, v79
    v_fma_f32 v80, -v96, v89, v80
    v_fma_f32 v81, -v97, v89, v81
    v_fma_f32 v82, -v98, v89, v82
    v_fma_f32 v83, -v99, v89, v83
    v_fmac_f32 v92, v76, v90
    v_fmac_f32 v93, v77, v90
    v_fmac_f32 v94, v78, v90
    v_fmac_f32 v95, v79, v90
    v_fmac_f32 v96, v80, v90
    v_fmac_f32 v97, v81, v90
    v_fmac_f32 v98, v82, v90
    v_fmac_f32 v99, v83, v90
    v_cvt_pk_bf16_f32 v72, v92, v93
    v_cvt_pk_bf16_f32 v73, v94, v95
    v_cvt_pk_bf16_f32 v74, v96, v97
    v_cvt_pk_bf16_f32 v75, v98, v99
    ds_write_b128 v22, v[72:75] offset:0
    v_add_u32 v28, 1, v25
    v_mov_b32 v29, 1
    v_not_b32 v31, v28
    s_mov_b64 exec, 0xff
    ds_write_b128 v22, v[28:31] offset:8384
    s_mov_b64 exec, -1
    ds_write_b64 v2, v[28:29] offset:8000
    v_readfirstlane_b32 s36, v28
    s_and_b32 s31, s29, 3
    s_lshr_b32 s32, s29, 2
    s_lshl_b32 s33, s28, 13
    s_lshl_b32 s34, s31, 11
    s_add_u32 s33, s33, s34
    s_lshl_b32 s34, s32, 8
    s_add_u32 s33, s33, s34
    s_add_u32 s33, s33, 65536
    v_add_u32 v12, s33, v3
    s_lshl_b32 s33, s28, 9
    s_add_u32 s33, s33, 4096
    v_and_b32 v14, 31, v1
    v_lshlrev_b32 v14, 4, v14
    v_add_u32 v14, s33, v14
    s_lshl_b32 s34, s29, 4
    s_add_u32 s33, s33, s34
    v_mov_b32 v15, s33
    s_lshl_b32 s33, s28, 16
    s_lshl_b32 s34, s29, 11
    s_add_u32 s33, s33, s34
    s_add_u32 s33, s33, 1048576
    v_add_u32 v18, s33, v3
    s_lshl_b32 s33, s28, 11
    s_add_u32 s33, s33, 393216
    v_and_b32 v97, 3, v1
    v_lshl_add_u32 v97, v97, 4, s33
    v_lshrrev_b32 v96, 2, v1
    v_add_u32 v96, s29, v96
    v_add_u32 v99, 16, v96
    v_and_b32 v96, 31, v96
    v_and_b32 v99, 31, v99
    v_lshl_add_u32 v98, v96, 6, v97
    v_lshl_add_u32 v99, v99, 6, v97
    s_and_b32 s33, s2, 31
    s_lshl_b32 s33, s33, 5
    v_and_b32 v23, 3, v1
    v_lshlrev_b32 v23, 3, v23
    v_bfe_u32 v20, v1, 2, 2
    v_lshl_add_u32 v23, v20, 1, v23
    v_add_u32 v23, s33, v23
    v_and_b32 v19, 3, v1
    v_lshlrev_b32 v19, 3, v19
    v_lshrrev_b32 v20, 4, v1
    v_lshl_add_u32 v19, v20, 1, v19
    v_add_u32 v19, v19, v2
    v_mov_b32 v21, 1
    s_getreg_b32 s39, hwreg(HW_REG_XCC_ID, 0, 4)
    s_waitcnt lgkmcnt(0)
    global_load_ushort v24, v23, s[4:5]
    v_mov_b32 v8, s39
    v_mov_b32 v9, 0
    v_mov_b32 v10, 0
    v_mov_b32 v11, s36
    s_mov_b64 exec, 1
    global_store_dwordx4 v15, v[8:11], s[26:27] sc1
    s_mov_b64 exec, -1
    v_mov_b32 v39, s36
    ds_read_b64 v[28:29], v2 offset:8016
    ds_read_b128 v[40:43], v22 offset:1024
    ds_read_b128 v[44:47], v22 offset:1280
    ds_read_b128 v[48:51], v22 offset:1536
    ds_read_b128 v[52:55], v22 offset:1792
    ds_read_b128 v[56:59], v22 offset:2048
    ds_read_b128 v[60:63], v22 offset:2304
    ds_read_b128 v[64:67], v22 offset:2560
    ds_read_b128 v[68:71], v22 offset:2816
    s_waitcnt lgkmcnt(0)
    v_and_b32 v28, v28, v29
    v_cmp_ne_u32 vcc, s3, v28
    s_cbranch_vccz L_r1d_12
    s_mov_b32 s35, 1048576
L_r1_11:
    ds_read_b64 v[28:29], v2 offset:8016
    s_waitcnt lgkmcnt(0)
    v_and_b32 v28, v28, v29
    v_cmp_ne_u32 vcc, s3, v28
    s_cbranch_vccz L_r1g_13
    s_sub_u32 s35, s35, 1
    s_cmp_lg_u32 s35, 0
    s_cbranch_scc1 L_r1_11
L_r1g_13:
    ds_read_b128 v[40:43], v22 offset:1024
    ds_read_b128 v[44:47], v22 offset:1280
    ds_read_b128 v[48:51], v22 offset:1536
    ds_read_b128 v[52:55], v22 offset:1792
    ds_read_b128 v[56:59], v22 offset:2048
    ds_read_b128 v[60:63], v22 offset:2304
    ds_read_b128 v[64:67], v22 offset:2560
    ds_read_b128 v[68:71], v22 offset:2816
    s_waitcnt lgkmcnt(0)
L_r1d_12:
    v_add_f32 v40, v40, v44
    v_add_f32 v48, v48, v52
    v_add_f32 v56, v56, v60
    v_add_f32 v64, v64, v68
    v_add_f32 v41, v41, v45
    v_add_f32 v49, v49, v53
    v_add_f32 v57, v57, v61
    v_add_f32 v65, v65, v69
    v_add_f32 v42, v42, v46
    v_add_f32 v50, v50, v54
    v_add_f32 v58, v58, v62
    v_add_f32 v66, v66, v70
    v_add_f32 v43, v43, v47
    v_add_f32 v51, v51, v55
    v_add_f32 v59, v59, v63
    v_add_f32 v67, v67, v71
    v_add_f32 v40, v40, v48
    v_add_f32 v56, v56, v64
    v_add_f32 v41, v41, v49
    v_add_f32 v57, v57, v65
    v_add_f32 v42, v42, v50
    v_add_f32 v58, v58, v66
    v_add_f32 v43, v43, v51
    v_add_f32 v59, v59, v67
    v_add_f32 v40, v40, v56
    v_add_f32 v41, v41, v57
    v_add_f32 v42, v42, v58
    v_add_f32 v43, v43, v59
    v_add_u32 v40, 0x80, v40
    v_add_u32 v41, 0x80, v41
    v_add_u32 v42, 0x80, v42
    v_add_u32 v43, 0x80, v43
    v_perm_b32 v36, v41, v40, s96
    v_perm_b32 v37, v42, v41, s97
    v_perm_b32 v38, v43, v42, s98
    s_mov_b64 exec, 0xffff
    global_store_dwordx4 v12, v[36:39], s[26:27]
    s_mov_b64 exec, -1
    v_mov_b32 v100, v36
    v_mov_b32 v101, v37
    v_mov_b32 v102, v38
    v_mov_b32 v103, v39
    s_mov_b32 s35, 1048576
L_thrx_14:
    ds_read_b32 v28, v2 offset:8128
    s_waitcnt lgkmcnt(0)
    v_cmp_gt_i32 vcc, 32, v28
    s_cbranch_vccz L_thrxd_15
    s_sub_u32 s35, s35, 1
    s_cmp_lg_u32 s35, 0
    s_cbranch_scc1 L_thrx_14
L_thrxd_15:
    global_load_dwordx4 v[28:31], v14, s[26:27] sc1
    s_mov_b32 s35, 65536
    s_waitcnt vmcnt(0)
L_xpoll_16:
    v_cmp_ne_u32 vcc, s36, v31
    s_cbranch_vccz L_xdone_17
    global_load_dwordx4 v[28:31], v14, s[26:27] sc1
    s_sub_u32 s35, s35, 1
    s_cmp_lg_u32 s35, 0
    s_waitcnt vmcnt(0)
    s_cbranch_scc1 L_xpoll_16
L_xdone_17:
    v_cmp_ne_u32 vcc, s39, v28
    s_cmp_eq_u64 vcc, 0
    s_cselect_b32 s37, 1, 2
    v_mov_b32 v25, s37
    ds_write_b32 v2, v25 offset:8008
    s_cmp_eq_u32 s37, 1
    s_cbranch_scc1 L_qloc_18
    v_add_u32 v104, 196608, v12
    s_mov_b64 exec, 0xffff
    global_store_dwordx4 v104, v[100:103], s[26:27] sc1
    s_mov_b64 exec, -1
L_qloc_18:
    s_mov_b32 s35, 1048576
L_thrml_19:
    ds_read_b32 v28, v2 offset:8128
    s_waitcnt lgkmcnt(0)
    v_cmp_gt_i32 vcc, 76, v28
    s_cbranch_vccz L_thrmld_20
    s_sub_u32 s35, s35, 1
    s_cmp_lg_u32 s35, 0
    s_cbranch_scc1 L_thrml_19
L_thrmld_20:
    global_load_dwordx4 v[48:51], v98, s[26:27] sc1
    global_load_dwordx4 v[52:55], v99, s[26:27] sc1
    s_mov_b32 s89, 0
    s_mov_b32 s35, 65536
    s_waitcnt vmcnt(0)
    v_cmp_ne_u32 vcc, s36, v51
    v_cmp_ne_u32 s[84:85], s36, v55
    s_or_b64 vcc, vcc, s[84:85]
    s_cbranch_scc0 L_mldone_22
    s_mov_b32 s89, 1
L_mlpoll_21:
    global_load_dwordx4 v[48:51], v98, s[26:27] sc1
    global_load_dwordx4 v[52:55], v99, s[26:27] sc1
    s_mov_b32 exec_lo, 0xfffffff0
    global_load_dwordx4 v[40:43], v18, s[26:27] sc1
    s_mov_b32 exec_lo, -1
    global_load_dwordx4 v[44:47], v18, s[26:27] offset:1024 sc1
    s_mov_b64 exec, 15
    ds_read_b128 v[40:43], v22 offset:8384
    s_mov_b64 exec, -1
    s_waitcnt vmcnt(0) lgkmcnt(0)
    v_cmp_ne_u32 vcc, s36, v51
    v_cmp_ne_u32 s[84:85], s36, v55
    s_or_b64 vcc, vcc, s[84:85]
    s_cbranch_scc0 L_mldone_22
    s_sub_u32 s35, s35, 1
    s_cmp_lg_u32 s35, 0
    s_cbranch_scc1 L_mlpoll_21
L_mldone_22:
    v_max_f32 v28, v48, v52
    s_nop 1
    v_max_f32_dpp v28, v28, v28 row_ror:4 row_mask:0xf bank_mask:0xf
    s_nop 1
    v_max_f32_dpp v28, v28, v28 row_ror:8 row_mask:0xf bank_mask:0xf
    v_mov_b32 v29, v28
    s_nop 1
    v_permlane16_swap_b32 v28, v29
    s_nop 0
    v_max_f32 v28, v28, v29
    v_mov_b32 v29, v28
    s_nop 1
    v_permlane32_swap_b32 v28, v29
    s_nop 0
    v_max_f32 v28, v28, v29
    v_sub_f32 v56, v48, v28
    v_sub_f32 v57, v52, v28
    v_mul_f32 v56, s93, v56
    v_mul_f32 v57, s93, v57
    v_exp_f32 v56, v56
    v_exp_f32 v57, v57
    s_nop 0
    v_mul_f32 v58, v56, v49
    v_fmac_f32 v58, v57, v53
    s_nop 1
    v_add_f32_dpp v58, v58, v58 row_ror:4 row_mask:0xf bank_mask:0xf
    s_nop 1
    v_add_f32_dpp v58, v58, v58 row_ror:8 row_mask:0xf bank_mask:0xf
    v_mov_b32 v59, v58
    s_nop 1
    v_permlane16_swap_b32 v58, v59
    s_nop 0
    v_add_f32 v58, v58, v59
    v_mov_b32 v59, v58
    s_nop 1
    v_permlane32_swap_b32 v58, v59
    s_nop 0
    v_add_f32 v58, v58, v59
    v_rcp_f32 v59, v58
    s_nop 0
    v_mul_f32 v120, v56, v59
    v_mul_f32 v121, v57, v59
    s_mov_b32 s35, 65536
    s_cmp_eq_u32 s89, 1
    s_cbranch_scc1 L_s2chk_23
    s_mov_b32 s35, 1048576
L_thrs2_26:
    ds_read_b32 v28, v2 offset:8128
    s_waitcnt lgkmcnt(0)
    v_cmp_gt_i32 vcc, 104, v28
    s_cbranch_vccz L_thrs2d_27
    s_sub_u32 s35, s35, 1
    s_cmp_lg_u32 s35, 0
    s_cbranch_scc1 L_thrs2_26
L_thrs2d_27:
    s_mov_b32 s35, 65536
L_s2poll_24:
    s_mov_b32 exec_lo, 0xfffffff0
    global_load_dwordx4 v[40:43], v18, s[26:27] sc1
    s_mov_b32 exec_lo, -1
    global_load_dwordx4 v[44:47], v18, s[26:27] offset:1024 sc1
    s_mov_b64 exec, 15
    ds_read_b128 v[40:43], v22 offset:8384
    s_mov_b64 exec, -1
    s_waitcnt vmcnt(0) lgkmcnt(0)
L_s2chk_23:
    v_cmp_ne_u32 vcc, s36, v43
    v_cmp_ne_u32 s[84:85], s36, v47
    s_or_b64 s[86:87], vcc, s[84:85]
    s_cbranch_scc0 L_s2done_25
    s_andn2_b64 vcc, vcc, 15
    s_or_b64 vcc, vcc, s[84:85]
    s_cbranch_scc0 L_s2ownw_28
    s_sub_u32 s35, s35, 1
    s_cmp_lg_u32 s35, 0
    s_cbranch_scc1 L_s2poll_24
    s_branch L_s2done_25
L_s2ownw_28:
    s_mov_b64 exec, 15
    s_mov_b32 s35, 1048576
L_s2ownl_29:
    ds_read_b128 v[40:43], v22 offset:8384
    s_waitcnt lgkmcnt(0)
    v_cmp_ne_u32 vcc, s36, v43
    s_cbranch_vccz L_s2ownd_30
    s_sub_u32 s35, s35, 1
    s_cmp_lg_u32 s35, 0
    s_cbranch_scc1 L_s2ownl_29
L_s2ownd_30:
    s_mov_b64 exec, -1
L_s2done_25:
    v_perm_b32 v65, v41, v40, s99
    v_perm_b32 v66, v42, v41, s100
    v_and_b32 v67, s101, v42
    v_lshlrev_b32 v64, 8, v40
    v_perm_b32 v69, v45, v44, s99
    v_perm_b32 v70, v46, v45, s100
    v_and_b32 v71, s101, v46
    v_lshlrev_b32 v68, 8, v44
    v_mul_f32 v124, v120, v64
    v_mul_f32 v125, v120, v65
    v_mul_f32 v126, v120, v66
    v_mul_f32 v127, v120, v67
    v_fmac_f32 v124, v121, v68
    v_fmac_f32 v125, v121, v69
    v_fmac_f32 v126, v121, v70
    v_fmac_f32 v127, v121, v71
    s_nop 1
    v_permlane32_swap_b32 v124, v126
    v_permlane32_swap_b32 v125, v127
    s_nop 0
    v_add_f32 v124, v124, v126
    v_add_f32 v125, v125, v127
    s_nop 1
    v_permlane16_swap_b32 v124, v125
    s_nop 0
    v_add_f32 v124, v124, v125
    s_nop 1
    v_add_f32_dpp v124, v124, v124 row_ror:8 row_mask:0xf bank_mask:0xf
    s_nop 1
    v_add_f32_dpp v124, v124, v124 row_ror:4 row_mask:0xf bank_mask:0xf
    v_cvt_pk_bf16_f32 v124, v124, v124
    s_mov_b32 exec_lo, 0x000f000f
    s_mov_b32 exec_hi, 0x000f000f
    ds_write_b16 v19, v124 offset:7424
    s_mov_b64 exec, -1
    ds_write_b32 v2, v21 offset:8056
    s_waitcnt vmcnt(0)
    s_cmp_ge_u32 s2, 32
    s_cbranch_scc1 L_fin
    v_and_b32 v26, 15, v1
    v_lshl_add_u32 v26, v26, 2, v2
    v_lshlrev_b32 v24, 16, v24
    s_mov_b32 s35, 1048576
L_fr_31:
    ds_read_b64 v[28:29], v2 offset:8064
    ds_read_b32 v40, v26 offset:7488
    ds_read_b32 v41, v26 offset:7552
    ds_read_b32 v42, v26 offset:7616
    ds_read_b32 v43, v26 offset:7680
    ds_read_b32 v44, v26 offset:7744
    ds_read_b32 v45, v26 offset:7808
    ds_read_b32 v46, v26 offset:7872
    ds_read_b32 v47, v26 offset:7936
    s_waitcnt lgkmcnt(0)
    v_and_b32 v28, v28, v29
    v_cmp_ne_u32 vcc, s3, v28
    s_cbranch_vccz L_frd_32
    s_sub_u32 s35, s35, 1
    s_cmp_lg_u32 s35, 0
    s_cbranch_scc1 L_fr_31
L_frd_32:
    v_add_f32 v40, v40, v41
    v_add_f32 v42, v42, v43
    v_add_f32 v44, v44, v45
    v_add_f32 v46, v46, v47
    v_add_f32 v40, v40, v42
    v_add_f32 v44, v44, v46
    v_add_f32 v40, v40, v44
    v_add_f32 v40, v40, v24
    v_cvt_pk_bf16_f32 v40, v40, v40
    s_mov_b64 exec, 0xffff
    global_store_short v23, v40, s[22:23]
    s_cmp_lg_u32 s2, 0
    s_cbranch_scc1 L_noepoch_33
    s_mov_b64 exec, 1
    v_mov_b32 v26, 0
    v_mov_b32 v27, s36
    global_store_dword v26, v27, s[26:27] sc1
L_noepoch_33:
    s_mov_b64 exec, -1
    s_branch L_fin
L_mlp:
    v_mov_b32 v2, 122880
    v_add_u32 v22, 122880, v3
    v_mov_b32 v21, 1
    s_mov_b32 s93, 0x3fb8aa3b
    s_mov_b32 s3, 0x01010101
    s_mov_b32 s96, 0x05030201
    s_mov_b32 s97, 0x06050302
    s_mov_b32 s98, 0x07060503
    s_mov_b32 s99, 0x0504030c
    s_mov_b32 s100, 0x0403020c
    s_mov_b32 s101, 0xffffff00
    s_mul_i32 s38, s28, 28
    s_add_u32 s38, s38, s29
    s_mul_i32 s33, s28, 7168
    s_lshl_b32 s34, s29, 8
    s_add_u32 s33, s33, s34
    s_add_u32 s33, s33, 196608
    v_add_u32 v13, s33, v3
    v_bfe_u32 v16, v1, 3, 1
    v_lshlrev_b32 v16, 2, v16
    v_and_b32 v17, 3, v1
    v_add_u32 v16, v16, v17
    v_mul_u32_u24 v16, 7168, v16
    v_bfe_u32 v17, v1, 2, 1
    v_lshl_add_u32 v16, v17, 4, v16
    s_lshl_b32 s33, s38, 5
    s_add_u32 s33, s33, 196608
    v_add_u32 v16, s33, v16
    s_barrier
    s_cmp_ge_u32 s29, 28
    s_cbranch_scc1 L_mlpdone_34
    s_mov_b32 s35, 1048576
L_mtag_35:
    ds_read_b64 v[28:29], v2 offset:8000
    s_waitcnt lgkmcnt(0)
    v_cmp_ne_u32 vcc, 1, v29
    s_cbranch_vccz L_mtagd_36
    s_sub_u32 s35, s35, 1
    s_cmp_lg_u32 s35, 0
    s_cbranch_scc1 L_mtag_35
L_mtagd_36:
    v_readfirstlane_b32 s36, v28
    v_mov_b32 v39, v28
    ds_read_b64 v[28:29], v2 offset:8024
    ds_read_b128 v[40:43], v22 offset:3072
    ds_read_b128 v[44:47], v22 offset:3328
    ds_read_b128 v[48:51], v22 offset:3584
    ds_read_b128 v[52:55], v22 offset:3840
    ds_read_b128 v[56:59], v22 offset:4096
    ds_read_b128 v[60:63], v22 offset:4352
    ds_read_b128 v[64:67], v22 offset:4608
    ds_read_b128 v[68:71], v22 offset:4864
    s_waitcnt lgkmcnt(0)
    v_and_b32 v28, v28, v29
    v_cmp_ne_u32 vcc, s3, v28
    s_cbranch_vccz L_r1md_38
    s_mov_b32 s35, 1048576
L_r1m_37:
    ds_read_b64 v[28:29], v2 offset:8024
    s_waitcnt lgkmcnt(0)
    v_and_b32 v28, v28, v29
    v_cmp_ne_u32 vcc, s3, v28
    s_cbranch_vccz L_r1mg_39
    s_sub_u32 s35, s35, 1
    s_cmp_lg_u32 s35, 0
    s_cbranch_scc1 L_r1m_37
L_r1mg_39:
    ds_read_b128 v[40:43], v22 offset:3072
    ds_read_b128 v[44:47], v22 offset:3328
    ds_read_b128 v[48:51], v22 offset:3584
    ds_read_b128 v[52:55], v22 offset:3840
    ds_read_b128 v[56:59], v22 offset:4096
    ds_read_b128 v[60:63], v22 offset:4352
    ds_read_b128 v[64:67], v22 offset:4608
    ds_read_b128 v[68:71], v22 offset:4864
    s_waitcnt lgkmcnt(0)
L_r1md_38:
    v_add_f32 v40, v40, v44
    v_add_f32 v48, v48, v52
    v_add_f32 v56, v56, v60
    v_add_f32 v64, v64, v68
    v_add_f32 v41, v41, v45
    v_add_f32 v49, v49, v53
    v_add_f32 v57, v57, v61
    v_add_f32 v65, v65, v69
    v_add_f32 v42, v42, v46
    v_add_f32 v50, v50, v54
    v_add_f32 v58, v58, v62
    v_add_f32 v66, v66, v70
    v_add_f32 v43, v43, v47
    v_add_f32 v51, v51, v55
    v_add_f32 v59, v59, v63
    v_add_f32 v67, v67, v71
    v_add_f32 v40, v40, v48
    v_add_f32 v56, v56, v64
    v_add_f32 v41, v41, v49
    v_add_f32 v57, v57, v65
    v_add_f32 v42, v42, v50
    v_add_f32 v58, v58, v66
    v_add_f32 v43, v43, v51
    v_add_f32 v59, v59, v67
    v_add_f32 v40, v40, v56
    v_add_f32 v41, v41, v57
    v_add_f32 v42, v42, v58
    v_add_f32 v43, v43, v59
    v_add_u32 v40, 0x80, v40
    v_add_u32 v41, 0x80, v41
    v_add_u32 v42, 0x80, v42
    v_add_u32 v43, 0x80, v43
    v_perm_b32 v36, v41, v40, s96
    v_perm_b32 v37, v42, v41, s97
    v_perm_b32 v38, v43, v42, s98
    s_mov_b64 exec, 0xffff
    global_store_dwordx4 v13, v[36:39], s[26:27] sc1
    s_mov_b64 exec, -1
    s_mov_b32 s35, 1048576
L_thrg_40:
    ds_read_b32 v28, v2 offset:8128
    s_waitcnt lgkmcnt(0)
    v_cmp_gt_i32 vcc, 72, v28
    s_cbranch_vccz L_thrgd_41
    s_sub_u32 s35, s35, 1
    s_cmp_lg_u32 s35, 0
    s_cbranch_scc1 L_thrg_40
L_thrgd_41:
    global_load_dwordx4 v[32:35], v16, s[26:27] sc1
    s_mov_b64 exec, 0xffff
    s_mov_b32 s35, 65536
    s_waitcnt vmcnt(0)
L_gpoll_42:
    v_cmp_ne_u32 vcc, s36, v35
    s_cbranch_vccz L_gdone_43
    global_load_dwordx4 v[32:35], v16, s[26:27] sc1
    s_sub_u32 s35, s35, 1
    s_cmp_lg_u32 s35, 0
    s_waitcnt vmcnt(0)
    s_cbranch_scc1 L_gpoll_42
L_gdone_43:
    v_perm_b32 v29, v33, v32, s99
    v_perm_b32 v30, v34, v33, s100
    v_and_b32 v31, s101, v34
    v_lshlrev_b32 v28, 8, v32
    s_nop 1
    v_add_f32_dpp v28, v28, v28 quad_perm:[1,0,3,2] row_mask:0xf bank_mask:0xf
    v_add_f32_dpp v29, v29, v29 quad_perm:[1,0,3,2] row_mask:0xf bank_mask:0xf
    v_add_f32_dpp v30, v30, v30 quad_perm:[1,0,3,2] row_mask:0xf bank_mask:0xf
    v_add_f32_dpp v31, v31, v31 quad_perm:[1,0,3,2] row_mask:0xf bank_mask:0xf
    v_add_f32_dpp v28, v28, v28 quad_perm:[2,3,0,1] row_mask:0xf bank_mask:0xf
    v_add_f32_dpp v29, v29, v29 quad_perm:[2,3,0,1] row_mask:0xf bank_mask:0xf
    v_add_f32_dpp v30, v30, v30 quad_perm:[2,3,0,1] row_mask:0xf bank_mask:0xf
    v_add_f32_dpp v31, v31, v31 quad_perm:[2,3,0,1] row_mask:0xf bank_mask:0xf
    v_cvt_pk_bf16_f32 v28, v28, v28
    v_lshlrev_b32 v28, 16, v28
    v_cvt_pk_bf16_f32 v29, v29, v29
    v_lshlrev_b32 v29, 16, v29
    v_cvt_pk_bf16_f32 v30, v30, v30
    v_lshlrev_b32 v30, 16, v30
    v_cvt_pk_bf16_f32 v31, v31, v31
    v_lshlrev_b32 v31, 16, v31
    s_nop 1
    v_mov_b32_dpp v32, v28 row_shl:8 row_mask:0xf bank_mask:0xf bound_ctrl:0
    v_mov_b32_dpp v33, v29 row_shl:8 row_mask:0xf bank_mask:0xf bound_ctrl:0
    v_mov_b32_dpp v34, v30 row_shl:8 row_mask:0xf bank_mask:0xf bound_ctrl:0
    v_mov_b32_dpp v35, v31 row_shl:8 row_mask:0xf bank_mask:0xf bound_ctrl:0
    v_mul_f32 v56, s93, v28
    v_mul_f32 v57, s93, v29
    v_mul_f32 v58, s93, v30
    v_mul_f32 v59, s93, v31
    v_exp_f32 v56, -v56
    v_exp_f32 v57, -v57
    v_exp_f32 v58, -v58
    v_exp_f32 v59, -v59
    s_nop 0
    v_add_f32 v56, 1.0, v56
    v_add_f32 v57, 1.0, v57
    v_add_f32 v58, 1.0, v58
    v_add_f32 v59, 1.0, v59
    v_rcp_f32 v60, v56
    v_rcp_f32 v61, v57
    v_rcp_f32 v62, v58
    v_rcp_f32 v63, v59
    s_nop 0
    v_mul_f32 v64, v28, v60
    v_mul_f32 v65, v29, v61
    v_mul_f32 v66, v30, v62
    v_mul_f32 v67, v31, v63
    v_fma_f32 v68, -v64, v56, v28
    v_fma_f32 v69, -v65, v57, v29
    v_fma_f32 v70, -v66, v58, v30
    v_fma_f32 v71, -v67, v59, v31
    v_fmac_f32 v64, v68, v60
    v_fmac_f32 v65, v69, v61
    v_fmac_f32 v66, v70, v62
    v_fmac_f32 v67, v71, v63
    v_cvt_pk_bf16_f32 v64, v64, v64
    v_lshlrev_b32 v64, 16, v64
    v_cvt_pk_bf16_f32 v65, v65, v65
    v_lshlrev_b32 v65, 16, v65
    v_cvt_pk_bf16_f32 v66, v66, v66
    v_lshlrev_b32 v66, 16, v66
    v_cvt_pk_bf16_f32 v67, v67, v67
    v_lshlrev_b32 v67, 16, v67
    v_mul_f32 v64, v64, v32
    v_mul_f32 v65, v65, v33
    v_mul_f32 v66, v66, v34
    v_mul_f32 v67, v67, v35
    v_cvt_pk_bf16_f32 v68, v64, v65
    v_cvt_pk_bf16_f32 v69, v66, v67
    v_bfe_u32 v27, v1, 2, 1
    v_lshl_add_u32 v27, v27, 3, v2
    s_mov_b64 exec, 0x11
    ds_write_b64 v27, v[68:69] offset:7456
    s_mov_b64 exec, -1
L_mlpdone_34:
    ds_write_b32 v2, v21 offset:8060
    s_waitcnt vmcnt(0) lgkmcnt(0)
    s_branch L_fin
L_compute:
    s_sub_u32 s30, s30, 2
    v_mov_b32 v2, 122880
    s_mov_b32 s3, 0x01010101
    v_mov_b32 v137, 1
    v_add_u32 v4, s30, v2
    v_mov_b32 v5, v4
    s_and_b32 s31, s29, 3
    s_and_b32 s90, s28, 3
    s_lshl_b32 s33, s30, 10
    v_add_u32 v136, s33, v3
    v_and_b32 v9, 7, v1
    v_lshlrev_b32 v116, 5, v9
    v_bfe_u32 v9, v1, 3, 3
    v_lshl_add_u32 v116, v9, 2, v116
    s_lshl_b32 s33, s30, 8
    s_add_u32 s33, s33, 122880
    v_add_u32 v116, s33, v116
    v_lshrrev_b32 v9, 3, v1
    v_lshl_add_u32 v9, v9, 1, v2
    s_lshl_b32 s33, s31, 8
    s_lshl_b32 s34, s30, 4
    s_add_u32 s33, s33, s34
    v_add_u32 v138, s33, v9
    s_lshl_b32 s33, s90, 8
    s_add_u32 s33, s33, s34
    v_add_u32 v139, s33, v9
    s_add_u32 s88, s30, 9
    s_add_u32 s89, s30, 25
    v_and_b32 v8, 3, v1
    v_bfe_u32 v9, v1, 2, 2
    s_lshl_b32 s33, s30, 2
    v_add_u32 v11, s33, v9
    v_mul_u32_u24 v126, 16640, v11
    v_lshl_add_u32 v126, v8, 4, v126
    s_lshl_b32 s33, s2, 6
    s_add_u32 s33, s33, 2097152
    v_add_u32 v126, s33, v126
    s_barrier
    s_mov_b32 s92, 0xffff0000
    s_mov_b32 s93, 0x3fb8aa3b
    s_mov_b32 s94, 0x3db504f3
    s_mov_b32 s96, 0x05030201
    s_mov_b32 s97, 0x06050302
    s_mov_b32 s98, 0x07060503
    s_mov_b32 s99, 0x0504030c
    s_mov_b32 s100, 0x0403020c
    s_mov_b32 s101, 0xffffff00
    s_cmp_lt_u32 s29, 28
    s_cselect_b32 s95, 1, 0
    v_and_b32 v8, 3, v1
    v_lshrrev_b32 v9, 4, v1
    v_bfe_u32 v10, v1, 2, 2
    v_and_b32 v15, 15, v1
    v_lshlrev_b32 v122, 4, v15
    v_lshl_add_u32 v122, v9, 11, v122
    s_lshl_b32 s33, s28, 13
    s_lshl_b32 s34, s30, 8
    s_add_u32 s33, s33, s34
    s_add_u32 s33, s33, 65536
    v_add_u32 v122, s33, v122
    v_lshl_add_u32 v11, v9, 3, v10
    v_lshlrev_b32 v11, 8, v11
    v_and_b32 v12, 1, v9
    v_lshlrev_b32 v12, 3, v12
    v_lshl_add_u32 v12, v10, 1, v12
    v_bfe_u32 v13, v1, 1, 1
    s_lshl_b32 s33, s30, 1
    v_add_u32 v13, s33, v13
    v_xor_b32 v13, v13, v12
    v_lshl_add_u32 v11, v13, 4, v11
    v_and_b32 v13, 1, v1
    v_lshl_add_u32 v121, v13, 3, v11
    v_add_u32 v121, 65536, v121
    v_xor_b32 v11, v9, v15
    v_lshlrev_b32 v11, 4, v11
    v_lshl_add_u32 v11, v15, 8, v11
    s_lshl_b32 s33, s30, 12
    s_add_u32 s33, s33, 32768
    v_add_u32 v130, s33, v11
    v_xor_b32 v131, 64, v130
    v_xor_b32 v132, 128, v130
    v_xor_b32 v133, 192, v130
    v_mul_u32_u24 v11, 272, v8
    v_add_u32 v11, v11, v2
    v_lshl_add_u32 v117, v9, 4, v11
    v_lshl_add_u32 v118, v9, 3, v11
    s_lshl_b32 s33, s30, 5
    v_add_u32 v118, s33, v118
    v_lshl_add_u32 v120, v8, 5, v2
    s_lshl_b32 s33, s30, 2
    v_add_u32 v119, s33, v120
    v_lshlrev_b32 v123, 3, v15
    v_lshl_add_u32 v123, v9, 1, v123
    s_lshr_b32 s33, s30, 1
    s_mul_i32 s33, s33, 272
    s_and_b32 s34, s30, 1
    s_lshl_b32 s34, s34, 7
    s_add_u32 s33, s33, s34
    s_add_u32 s33, s33, 122880
    v_add_u32 v123, s33, v123
    v_mul_u32_u24 v124, 272, v8
    v_add_u32 v124, v124, v2
    v_lshl_add_u32 v124, v9, 4, v124
    v_lshlrev_b32 v125, 4, v8
    v_lshl_add_u32 v125, v9, 11, v125
    s_lshl_b32 s33, s28, 16
    s_lshl_b32 s34, s30, 13
    s_add_u32 s33, s33, s34
    s_lshl_b32 s34, s30, 2
    v_add_u32 v12, s34, v9
    v_sub_u32 v12, s29, v12
    v_and_b32 v12, 31, v12
    v_lshl_add_u32 v125, v12, 6, v125
    v_lshl_add_u32 v141, v8, 4, v2
    s_and_b32 s34, s29, 3
    s_lshl_b32 s34, s34, 4
    s_mov_b64 s[74:75], 15
    s_lshl_b64 s[74:75], s[74:75], s34
    s_lshr_b32 s34, s29, 2
    s_cmp_eq_u32 s34, s30
    s_cselect_b64 s[74:75], s[74:75], 0
    s_add_u32 s33, s33, 1048576
    v_add_u32 v125, s33, v125
    s_lshl_b32 s33, s28, 11
    s_lshl_b32 s34, s29, 6
    s_add_u32 s33, s33, s34
    s_add_u32 s33, s33, 393216
    v_lshl_add_u32 v142, v8, 4, s33
    v_and_b32 v12, 1, v9
    s_lshl_b32 s33, s95, 1
    v_cmp_eq_u32 vcc, s33, v9
    s_nop 1
    v_cndmask_b32 v12, v12, v9, vcc
    v_lshl_add_u32 v12, v12, 3, v10
    v_lshlrev_b32 v12, 10, v12
    v_and_b32 v13, 1, v10
    v_bfe_u32 v14, v10, 1, 1
    v_lshl_add_u32 v13, v14, 3, v13
    s_lshl_b32 s33, s30, 3
    v_lshl_add_u32 v14, v8, 1, s33
    v_xor_b32 v14, v14, v13
    v_lshl_add_u32 v127, v14, 4, v12
    v_add_u32 v127, 98304, v127
    v_xor_b32 v128, 16, v127
    v_lshl_add_u32 v129, v9, 4, v2
    s_mul_i32 s33, s2, 16640
    s_lshl_b32 s34, s30, 11
    s_add_u32 s33, s33, s34
    s_add_u32 s33, s33, 2097152
    v_add_u32 v134, s33, v3
    v_lshl_add_u32 v135, v8, 4, v2
    v_lshl_add_u32 v135, v9, 2, v135
    s_lshl_b32 s33, s30, 6
    v_add_u32 v135, s33, v135
    s_lshl_b32 s91, s30, 2
    s_add_u32 s91, s91, 36
    s_mov_b32 s35, 1048576
L_xn_46:
    ds_read_b64 v[12:13], v2 offset:8000
    ds_read_u16 v88, v138 offset:0
    ds_read_u16 v89, v138 offset:128
    ds_read_u16 v92, v139 offset:0
    ds_read_u16 v93, v139 offset:128
    s_waitcnt lgkmcnt(0)
    v_cmp_ne_u32 vcc, 1, v13
    s_cbranch_vccz L_xnd_47
    s_sub_u32 s35, s35, 1
    s_cmp_lg_u32 s35, 0
    s_cbranch_scc1 L_xn_46
L_xnd_47:
    v_readfirstlane_b32 s36, v12
    v_lshlrev_b32 v90, 16, v88
    v_lshlrev_b32 v91, 16, v89
    v_lshlrev_b32 v94, 16, v92
    v_lshlrev_b32 v95, 16, v93
    s_mov_b32 s72, 1
L_gvwait_44:
    ds_read_b32 v8, v2 offset:8128
    ds_read_b128 v[20:23], v136
    ds_read_b128 v[24:27], v136 offset:8192
    s_waitcnt lgkmcnt(0)
    v_cmp_gt_i32 vcc, s88, v8
    s_cbranch_vccz L_wqd_49
    s_mov_b32 s35, 1048576
L_wq_48:
    ds_read_b32 v8, v2 offset:8128
    s_waitcnt lgkmcnt(0)
    v_cmp_gt_i32 vcc, s88, v8
    s_cbranch_vccz L_wqg_50
    s_sub_u32 s35, s35, 1
    s_cmp_lg_u32 s35, 0
    s_cbranch_scc1 L_wq_48
L_wqg_50:
    ds_read_b128 v[20:23], v136
    ds_read_b128 v[24:27], v136 offset:8192
    s_waitcnt lgkmcnt(0)
L_wqd_49:
    v_dot2_f32_bf16 v80, v20, v88, 0
    v_dot2_f32_bf16 v81, v20, v90, 0
    v_dot2_f32_bf16 v82, v21, v88, 0
    v_dot2_f32_bf16 v83, v21, v90, 0
    v_dot2_f32_bf16 v84, v22, v88, 0
    v_dot2_f32_bf16 v85, v22, v90, 0
    v_dot2_f32_bf16 v86, v23, v88, 0
    v_dot2_f32_bf16 v87, v23, v90, 0
    v_dot2_f32_bf16 v80, v24, v89, v80
    v_dot2_f32_bf16 v81, v24, v91, v81
    v_dot2_f32_bf16 v82, v25, v89, v82
    v_dot2_f32_bf16 v83, v25, v91, v83
    v_dot2_f32_bf16 v84, v26, v89, v84
    v_dot2_f32_bf16 v85, v26, v91, v85
    v_dot2_f32_bf16 v86, v27, v89, v86
    v_dot2_f32_bf16 v87, v27, v91, v87
    s_nop 3
    v_permlane32_swap_b32 v80, v84
    v_permlane32_swap_b32 v81, v85
    v_permlane32_swap_b32 v82, v86
    v_permlane32_swap_b32 v83, v87
    s_nop 0
    v_add_f32 v80, v80, v84
    v_add_f32 v81, v81, v85
    v_add_f32 v82, v82, v86
    v_add_f32 v83, v83, v87
    s_nop 1
    v_permlane16_swap_b32 v80, v82
    v_permlane16_swap_b32 v81, v83
    s_nop 0
    v_add_f32 v80, v80, v82
    v_add_f32 v81, v81, v83
    s_nop 1
    v_add_f32_dpp v8, v80, v80 row_ror:8 row_mask:0xf bank_mask:0x3
    v_add_f32_dpp v8, v81, v81 row_ror:8 row_mask:0xf bank_mask:0xc
    ds_write_b32 v116, v8 offset:1024
    ds_write_b8 v5, v137 offset:8016
    s_cmp_eq_u32 s72, 2
    s_cbranch_scc1 L_gvdone_45
    s_not_b32 s33, s36
    v_mov_b32 v87, s33
    s_mov_b64 exec, 0xffff
    global_store_dwordx4 v126, v[84:87], s[26:27] sc1
    s_mov_b64 exec, -1
    v_mov_b32 v88, v92
    v_mov_b32 v89, v93
    v_mov_b32 v90, v94
    v_mov_b32 v91, v95
    v_add_u32 v136, 16384, v136
    v_add_u32 v116, 2048, v116
    v_add_u32 v5, 8, v5
    s_mov_b32 s88, s89
    s_mov_b32 s72, 2
    s_branch L_gvwait_44
L_gvdone_45:
    v_mov_b32 v80, 0x3f803f80
    v_mov_b32 v81, 0x3f803f80
    v_mov_b32 v82, 0x3f803f80
    v_mov_b32 v83, 0x3f803f80
    s_mov_b32 s35, 1048576
L_thrq_51:
    ds_read_b32 v8, v2 offset:8128
    s_waitcnt lgkmcnt(0)
    v_cmp_gt_i32 vcc, 44, v8
    s_cbranch_vccz L_thrqd_52
    s_sub_u32 s35, s35, 1
    s_cmp_lg_u32 s35, 0
    s_cbranch_scc1 L_thrq_51
L_thrqd_52:
    global_load_dwordx4 v[84:87], v122, s[26:27] sc1
    s_mov_b32 s35, 1048576
L_thrq2_53:
    ds_read_b32 v8, v2 offset:8128
    s_waitcnt lgkmcnt(0)
    v_cmp_gt_i32 vcc, 56, v8
    s_cbranch_vccz L_thrq2d_54
    s_sub_u32 s35, s35, 1
    s_cmp_lg_u32 s35, 0
    s_cbranch_scc1 L_thrq2_53
L_thrq2d_54:
    global_load_dwordx4 v[64:67], v122, s[26:27] sc1
    ds_read_b32 v8, v2 offset:8128
    s_mov_b32 s89, 0
    s_waitcnt lgkmcnt(0)
    v_cmp_gt_i32 vcc, s91, v8
    s_cbranch_vccnz L_klate_55
    ds_read_b128 v[32:35], v130
    ds_read_b128 v[36:39], v131
    ds_read_b128 v[40:43], v132
    ds_read_b128 v[44:47], v133
    s_mov_b32 s89, 1
L_klate_55:
    s_waitcnt vmcnt(1)
    v_cmp_ne_u32 vcc, s36, v87
    s_cbranch_vccz L_qdone_56
    s_waitcnt vmcnt(0)
    v_mov_b32 v84, v64
    v_mov_b32 v85, v65
    v_mov_b32 v86, v66
    v_mov_b32 v87, v67
    s_mov_b32 s35, 65536
L_qpoll_57:
    v_cmp_ne_u32 vcc, s36, v87
    s_cbranch_vccz L_qdone_56
    ds_read_b32 v8, v2 offset:8008
    v_add_u32 v9, 196608, v122
    s_waitcnt lgkmcnt(0)
    v_cmp_eq_u32 vcc, 2, v8
    s_nop 1
    v_cndmask_b32 v9, v122, v9, vcc
    global_load_dwordx4 v[84:87], v9, s[26:27] sc1
    s_sub_u32 s35, s35, 1
    s_cmp_lg_u32 s35, 0
    s_waitcnt vmcnt(0)
    s_cbranch_scc1 L_qpoll_57
L_qdone_56:
    v_perm_b32 v97, v85, v84, s99
    v_perm_b32 v98, v86, v85, s100
    v_and_b32 v99, s101, v86
    v_lshlrev_b32 v96, 8, v84
    s_nop 1
    v_permlane32_swap_b32 v96, v98
    v_permlane32_swap_b32 v97, v99
    s_nop 0
    v_add_f32 v96, v96, v98
    v_add_f32 v97, v97, v99
    s_nop 1
    v_permlane16_swap_b32 v96, v97
    s_nop 0
    v_add_f32 v96, v96, v97
    v_cvt_pk_bf16_f32 v96, v96, v96
    ds_write_b16 v123, v96 offset:5120
    ds_write_b8 v4, v137 offset:8032
    s_cmp_eq_u32 s89, 1
    s_cbranch_scc1 L_kdone_58
    s_mov_b32 s35, 1048576
L_kk_59:
    ds_read_b32 v8, v2 offset:8128
    s_waitcnt lgkmcnt(0)
    v_cmp_gt_i32 vcc, s91, v8
    s_cbranch_vccz L_kkg_61
    s_sub_u32 s35, s35, 1
    s_cmp_lg_u32 s35, 0
    s_cbranch_scc1 L_kk_59
L_kkg_61:
    ds_read_b128 v[32:35], v130
    ds_read_b128 v[36:39], v131
    ds_read_b128 v[40:43], v132
    ds_read_b128 v[44:47], v133
    s_waitcnt lgkmcnt(0)
L_kkd_60:
L_kdone_58:
    s_mov_b32 s35, 1048576
L_qf_62:
    ds_read_b64 v[8:9], v2 offset:8032
    s_waitcnt lgkmcnt(0)
    v_and_b32 v8, v8, v9
    v_cmp_ne_u32 vcc, s3, v8
    s_cbranch_vccz L_qfg_64
    s_sub_u32 s35, s35, 1
    s_cmp_lg_u32 s35, 0
    s_cbranch_scc1 L_qf_62
L_qfg_64:
    ds_read_b128 v[48:51], v124 offset:5120
    ds_read_b128 v[52:55], v124 offset:5184
    ds_read_b128 v[56:59], v124 offset:5248
    ds_read_b128 v[60:63], v124 offset:5312
    s_waitcnt lgkmcnt(0)
L_qfd_63:
    v_mfma_f32_16x16x32_bf16 v[112:115], v[32:35], v[48:51], 0
    v_mfma_f32_16x16x32_bf16 v[112:115], v[36:39], v[52:55], v[112:115]
    v_mfma_f32_16x16x32_bf16 v[112:115], v[40:43], v[56:59], v[112:115]
    v_mfma_f32_16x16x32_bf16 v[112:115], v[44:47], v[60:63], v[112:115]
    s_nop 9
    v_cvt_pk_bf16_f32 v96, v112, v113
    v_cvt_pk_bf16_f32 v97, v114, v115
    v_lshlrev_b32 v112, 16, v96
    v_and_b32 v113, s92, v96
    v_lshlrev_b32 v114, 16, v97
    v_and_b32 v115, s92, v97
    v_mul_f32 v112, s94, v112
    v_mul_f32 v113, s94, v113
    v_mul_f32 v114, s94, v114
    v_mul_f32 v115, s94, v115
    v_cvt_pk_bf16_f32 v96, v112, v113
    v_cvt_pk_bf16_f32 v97, v114, v115
    v_lshlrev_b32 v112, 16, v96
    v_and_b32 v113, s92, v96
    v_lshlrev_b32 v114, 16, v97
    v_and_b32 v115, s92, v97
    v_max3_f32 v98, v112, v113, v114
    v_max_f32 v98, v98, v115
    v_mov_b32 v99, v98
    s_nop 1
    v_permlane16_swap_b32 v98, v99
    s_nop 0
    v_max_f32 v98, v98, v99
    v_mov_b32 v99, v98
    s_nop 1
    v_permlane32_swap_b32 v98, v99
    s_nop 0
    v_max_f32 v98, v98, v99
    s_mov_b64 exec, 15
    ds_write_b32 v119, v98 offset:6208
    s_mov_b64 exec, -1
    ds_write_b8 v4, v137 offset:8040
    s_mov_b32 s35, 1048576
L_mx_65:
    ds_read_b64 v[8:9], v2 offset:8040
    ds_read_b128 v[100:103], v120 offset:6208
    ds_read_b128 v[104:107], v120 offset:6224
    s_waitcnt lgkmcnt(0)
    v_and_b32 v8, v8, v9
    v_cmp_ne_u32 vcc, s3, v8
    s_cbranch_vccz L_mxd_66
    s_sub_u32 s35, s35, 1
    s_cmp_lg_u32 s35, 0
    s_cbranch_scc1 L_mx_65
L_mxd_66:
    v_max3_f32 v98, v100, v101, v102
    v_max3_f32 v99, v103, v104, v105
    v_max3_f32 v98, v98, v106, v107
    v_max_f32 v84, v98, v99
    v_sub_f32 v112, v112, v84
    v_sub_f32 v113, v113, v84
    v_sub_f32 v114, v114, v84
    v_sub_f32 v115, v115, v84
    v_mul_f32 v112, s93, v112
    v_mul_f32 v113, s93, v113
    v_mul_f32 v114, s93, v114
    v_mul_f32 v115, s93, v115
    v_exp_f32 v112, v112
    v_exp_f32 v113, v113
    v_exp_f32 v114, v114
    v_exp_f32 v115, v115
    s_nop 0
    v_cvt_pk_bf16_f32 v96, v112, v113
    v_cvt_pk_bf16_f32 v97, v114, v115
    s_mov_b32 exec_lo, 0x000f000f
    s_mov_b32 exec_hi, 0x000f000f
    ds_write_b64 v118, v[96:97] offset:6336
    s_mov_b64 exec, -1
    ds_write_b8 v4, v137 offset:8048
    v_mov_b32 v86, 0
    v_mov_b32 v87, s36
    v_mov_b32 v99, s36
    s_mov_b32 s35, 1048576
L_pf_67:
    ds_read_b64 v[8:9], v2 offset:8048
    ds_read_b32 v10, v2 offset:8008
    s_waitcnt lgkmcnt(0)
    v_and_b32 v8, v8, v9
    v_cmp_ne_u32 vcc, s3, v8
    v_cmp_eq_u32 s[86:87], 0, v10
    s_or_b64 vcc, vcc, s[86:87]
    s_cbranch_vccz L_pfg_69
    s_sub_u32 s35, s35, 1
    s_cmp_lg_u32 s35, 0
    s_cbranch_scc1 L_pf_67
L_pfg_69:
    ds_read_b128 v[48:51], v117 offset:6336
    ds_read_b128 v[52:55], v117 offset:6400
    ds_read_b128 v[56:59], v117 offset:6464
    ds_read_b128 v[60:63], v117 offset:6528
    s_waitcnt lgkmcnt(0)
L_pfd_68:
    v_readfirstlane_b32 s37, v10
    s_waitcnt vmcnt(0)
    s_cmp_lg_u32 s30, 0
    s_cbranch_scc1 L_mlskip_70
    v_mfma_f32_16x16x32_bf16 v[24:27], v[80:83], v[48:51], 0
    v_mfma_f32_16x16x32_bf16 v[24:27], v[80:83], v[52:55], v[24:27]
    v_mfma_f32_16x16x32_bf16 v[24:27], v[80:83], v[56:59], v[24:27]
    v_mfma_f32_16x16x32_bf16 v[24:27], v[80:83], v[60:63], v[24:27]
    s_nop 7
    v_mov_b32 v85, v24
    s_mov_b64 exec, 15
    s_cmp_eq_u32 s37, 1
    s_cbranch_scc0 L_mlglob_71
    global_store_dwordx4 v142, v[84:87], s[26:27]
    s_branch L_mlskip_70x
L_mlglob_71:
    global_store_dwordx4 v142, v[84:87], s[26:27] sc1
L_mlskip_70x:
    s_mov_b64 exec, -1
L_mlskip_70:
    ds_read_b32 v8, v2 offset:8128
    ds_read_b64_tr_b16 v[64:65], v121 offset:0
    ds_read_b64_tr_b16 v[66:67], v121 offset:1024
    s_waitcnt lgkmcnt(0)
    v_cmp_gt_i32 vcc, 72, v8
    s_cbranch_vccz L_vvd_73
    s_mov_b32 s35, 1048576
L_vv_72:
    ds_read_b32 v8, v2 offset:8128
    s_waitcnt lgkmcnt(0)
    v_cmp_gt_i32 vcc, 72, v8
    s_cbranch_vccz L_vvg_74
    s_sub_u32 s35, s35, 1
    s_cmp_lg_u32 s35, 0
    s_cbranch_scc1 L_vv_72
L_vvg_74:
    ds_read_b64_tr_b16 v[64:65], v121 offset:0
    ds_read_b64_tr_b16 v[66:67], v121 offset:1024
    s_waitcnt lgkmcnt(0)
L_vvd_73:
    v_mfma_f32_16x16x32_bf16 v[20:23], v[64:67], v[48:51], 0
    ds_read_b32 v8, v2 offset:8128
    ds_read_b64_tr_b16 v[68:69], v121 offset:8192
    ds_read_b64_tr_b16 v[70:71], v121 offset:9216
    s_waitcnt lgkmcnt(0)
    v_cmp_gt_i32 vcc, 80, v8
    s_cbranch_vccz L_vvd_76
    s_mov_b32 s35, 1048576
L_vv_75:
    ds_read_b32 v8, v2 offset:8128
    s_waitcnt lgkmcnt(0)
    v_cmp_gt_i32 vcc, 80, v8
    s_cbranch_vccz L_vvg_77
    s_sub_u32 s35, s35, 1
    s_cmp_lg_u32 s35, 0
    s_cbranch_scc1 L_vv_75
L_vvg_77:
    ds_read_b64_tr_b16 v[68:69], v121 offset:8192
    ds_read_b64_tr_b16 v[70:71], v121 offset:9216
    s_waitcnt lgkmcnt(0)
L_vvd_76:
    v_mfma_f32_16x16x32_bf16 v[20:23], v[68:71], v[52:55], v[20:23]
    ds_read_b32 v8, v2 offset:8128
    ds_read_b64_tr_b16 v[72:73], v121 offset:16384
    ds_read_b64_tr_b16 v[74:75], v121 offset:17408
    s_waitcnt lgkmcnt(0)
    v_cmp_gt_i32 vcc, 88, v8
    s_cbranch_vccz L_vvd_79
    s_mov_b32 s35, 1048576
L_vv_78:
    ds_read_b32 v8, v2 offset:8128
    s_waitcnt lgkmcnt(0)
    v_cmp_gt_i32 vcc, 88, v8
    s_cbranch_vccz L_vvg_80
    s_sub_u32 s35, s35, 1
    s_cmp_lg_u32 s35, 0
    s_cbranch_scc1 L_vv_78
L_vvg_80:
    ds_read_b64_tr_b16 v[72:73], v121 offset:16384
    ds_read_b64_tr_b16 v[74:75], v121 offset:17408
    s_waitcnt lgkmcnt(0)
L_vvd_79:
    v_mfma_f32_16x16x32_bf16 v[20:23], v[72:75], v[56:59], v[20:23]
    ds_read_b32 v8, v2 offset:8128
    ds_read_b64_tr_b16 v[76:77], v121 offset:24576
    ds_read_b64_tr_b16 v[78:79], v121 offset:25600
    s_waitcnt lgkmcnt(0)
    v_cmp_gt_i32 vcc, 96, v8
    s_cbranch_vccz L_vvd_82
    s_mov_b32 s35, 1048576
L_vv_81:
    ds_read_b32 v8, v2 offset:8128
    s_waitcnt lgkmcnt(0)
    v_cmp_gt_i32 vcc, 96, v8
    s_cbranch_vccz L_vvg_83
    s_sub_u32 s35, s35, 1
    s_cmp_lg_u32 s35, 0
    s_cbranch_scc1 L_vv_81
L_vvg_83:
    ds_read_b64_tr_b16 v[76:77], v121 offset:24576
    ds_read_b64_tr_b16 v[78:79], v121 offset:25600
    s_waitcnt lgkmcnt(0)
L_vvd_82:
    v_mfma_f32_16x16x32_bf16 v[20:23], v[76:79], v[60:63], v[20:23]
    s_mov_b32 exec_lo, 0x000f000f
    s_mov_b32 exec_hi, 0x000f000f
    s_nop 5
    v_add_u32 v20, 0x80, v20
    v_add_u32 v21, 0x80, v21
    v_add_u32 v22, 0x80, v22
    v_add_u32 v23, 0x80, v23
    v_perm_b32 v96, v21, v20, s96
    v_perm_b32 v97, v22, v21, s97
    v_perm_b32 v98, v23, v22, s98
    s_cmp_eq_u32 s37, 1
    s_cbranch_scc0 L_s2glob_84
    global_store_dwordx4 v125, v[96:99], s[26:27]
    s_branch L_s2join_85
L_s2glob_84:
    global_store_dwordx4 v125, v[96:99], s[26:27] sc1
L_s2join_85:
    s_mov_b64 exec, s[74:75]
    ds_write_b128 v141, v[96:99] offset:8384
    s_mov_b64 exec, -1
    ds_read_b32 v8, v2 offset:8128
    ds_read_b64_tr_b16 v[32:33], v127 offset:0
    ds_read_b64_tr_b16 v[34:35], v127 offset:4096
    ds_read_b64_tr_b16 v[36:37], v127 offset:8
    ds_read_b64_tr_b16 v[38:39], v127 offset:4104
    ds_read_b64_tr_b16 v[40:41], v128 offset:0
    ds_read_b64_tr_b16 v[42:43], v128 offset:4096
    ds_read_b64_tr_b16 v[44:45], v128 offset:8
    ds_read_b64_tr_b16 v[46:47], v128 offset:4104
    s_waitcnt lgkmcnt(0)
    v_cmp_gt_i32 vcc, 120, v8
    s_cbranch_vccz L_wwd_87
    s_mov_b32 s35, 1048576
L_ww_86:
    ds_read_b32 v8, v2 offset:8128
    s_waitcnt lgkmcnt(0)
    v_cmp_gt_i32 vcc, 120, v8
    s_cbranch_vccz L_wwg_88
    s_sub_u32 s35, s35, 1
    s_cmp_lg_u32 s35, 0
    s_cbranch_scc1 L_ww_86
L_wwg_88:
    ds_read_b64_tr_b16 v[32:33], v127 offset:0
    ds_read_b64_tr_b16 v[34:35], v127 offset:4096
    ds_read_b64_tr_b16 v[36:37], v127 offset:8
    ds_read_b64_tr_b16 v[38:39], v127 offset:4104
    ds_read_b64_tr_b16 v[40:41], v128 offset:0
    ds_read_b64_tr_b16 v[42:43], v128 offset:4096
    ds_read_b64_tr_b16 v[44:45], v128 offset:8
    ds_read_b64_tr_b16 v[46:47], v128 offset:4104
    s_waitcnt lgkmcnt(0)
L_wwd_87:
    v_mov_b32 v87, s36
    s_mov_b32 s35, 1048576
L_av_89:
    ds_read_b64 v[8:9], v2 offset:8056
    ds_read_b128 v[48:51], v129 offset:7424
    s_waitcnt lgkmcnt(0)
    v_and_b32 v8, v8, v9
    v_cmp_ne_u32 vcc, 1, v8
    s_cbranch_vccz L_avd_90
    s_sub_u32 s35, s35, 1
    s_cmp_lg_u32 s35, 0
    s_cbranch_scc1 L_av_89
L_avd_90:
    v_mfma_f32_16x16x32_bf16 v[96:99], v[48:51], v[32:35], 0
    v_mfma_f32_16x16x32_bf16 v[100:103], v[48:51], v[36:39], 0
    v_mfma_f32_16x16x32_bf16 v[104:107], v[48:51], v[40:43], 0
    v_mfma_f32_16x16x32_bf16 v[108:111], v[48:51], v[44:47], 0
    s_mov_b64 exec, 0xffff
    s_nop 6
    v_add_u32 v96, 0x80, v96
    v_add_u32 v100, 0x80, v100
    v_add_u32 v104, 0x80, v104
    v_add_u32 v108, 0x80, v108
    v_perm_b32 v84, v100, v96, s96
    v_perm_b32 v85, v104, v100, s97
    v_perm_b32 v86, v108, v104, s98
    global_store_dwordx4 v126, v[84:87], s[26:27] sc1
    s_mov_b64 exec, -1
    s_cmp_ge_u32 s2, 32
    s_cbranch_scc1 L_fin
    s_sleep 8
    s_mov_b32 s35, 65536
    global_load_dwordx4 v[96:99], v134, s[26:27] sc1
    global_load_dwordx4 v[100:103], v134, s[26:27] offset:1024 sc1
    s_sleep 4
    global_load_dwordx4 v[48:51], v134, s[26:27] sc1
    global_load_dwordx4 v[52:55], v134, s[26:27] offset:1024 sc1
    s_sleep 4
L_opoll_91:
    global_load_dwordx4 v[64:67], v134, s[26:27] sc1
    global_load_dwordx4 v[68:71], v134, s[26:27] offset:1024 sc1
    s_waitcnt vmcnt(4)
    v_cmp_ne_u32 vcc, s36, v99
    v_cmp_ne_u32 s[84:85], s36, v103
    s_or_b64 vcc, vcc, s[84:85]
    s_cbranch_scc0 L_odone_93
    global_load_dwordx4 v[96:99], v134, s[26:27] sc1
    global_load_dwordx4 v[100:103], v134, s[26:27] offset:1024 sc1
    s_waitcnt vmcnt(4)
    v_cmp_ne_u32 vcc, s36, v51
    v_cmp_ne_u32 s[84:85], s36, v55
    s_or_b64 vcc, vcc, s[84:85]
    s_cbranch_scc0 L_odone_94
    global_load_dwordx4 v[48:51], v134, s[26:27] sc1
    global_load_dwordx4 v[52:55], v134, s[26:27] offset:1024 sc1
    s_waitcnt vmcnt(4)
    v_cmp_ne_u32 vcc, s36, v67
    v_cmp_ne_u32 s[84:85], s36, v71
    s_or_b64 vcc, vcc, s[84:85]
    s_cbranch_scc0 L_odone_95
    s_sub_u32 s35, s35, 1
    s_cmp_lg_u32 s35, 0
    s_cbranch_scc1 L_opoll_91
L_odone_95:
    v_perm_b32 v33, v65, v64, s99
    v_perm_b32 v34, v66, v65, s100
    v_and_b32 v35, s101, v66
    v_lshlrev_b32 v32, 8, v64
    v_perm_b32 v37, v69, v68, s99
    v_perm_b32 v38, v70, v69, s100
    v_and_b32 v39, s101, v70
    v_lshlrev_b32 v36, 8, v68
    s_branch L_ocommon_96
L_odone_94:
    v_perm_b32 v33, v49, v48, s99
    v_perm_b32 v34, v50, v49, s100
    v_and_b32 v35, s101, v50
    v_lshlrev_b32 v32, 8, v48
    v_perm_b32 v37, v53, v52, s99
    v_perm_b32 v38, v54, v53, s100
    v_and_b32 v39, s101, v54
    v_lshlrev_b32 v36, 8, v52
    s_branch L_ocommon_96
L_odone_93:
    v_perm_b32 v33, v97, v96, s99
    v_perm_b32 v34, v98, v97, s100
    v_and_b32 v35, s101, v98
    v_lshlrev_b32 v32, 8, v96
    v_perm_b32 v37, v101, v100, s99
    v_perm_b32 v38, v102, v101, s100
    v_and_b32 v39, s101, v102
    v_lshlrev_b32 v36, 8, v100
L_ocommon_96:
    v_add_f32 v104, v32, v36
    v_add_f32 v105, v33, v37
    v_add_f32 v106, v34, v38
    v_add_f32 v107, v35, v39
    s_nop 1
    v_permlane32_swap_b32 v104, v106
    v_permlane32_swap_b32 v105, v107
    s_nop 0
    v_add_f32 v104, v104, v106
    v_add_f32 v105, v105, v107
    s_nop 1
    v_permlane16_swap_b32 v104, v105
    s_nop 0
    v_add_f32 v104, v104, v105
    s_nop 1
    v_add_f32_dpp v104, v104, v104 row_ror:8 row_mask:0xf bank_mask:0xf
    s_nop 1
    v_add_f32_dpp v104, v104, v104 row_ror:4 row_mask:0xf bank_mask:0xf
    s_mov_b32 exec_lo, 0x000f000f
    s_mov_b32 exec_hi, 0x000f000f
    ds_write_b32 v135, v104 offset:7488
    s_mov_b64 exec, -1
    ds_write_b8 v4, v137 offset:8064
L_fin:
L_end:
    s_endpgm
.section .rodata,"a"
.p2align 6
.amdhsa_kernel parallel_sum__sliding_block_cached__glu_gated_swiglu__decode_kernel
  .amdhsa_next_free_vgpr 144
  .amdhsa_next_free_sgpr 102
  .amdhsa_accum_offset 144
  .amdhsa_group_segment_fixed_size 0
  .amdhsa_kernarg_size 96
  .amdhsa_user_sgpr_count 2
  .amdhsa_user_sgpr_kernarg_segment_ptr 1
  .amdhsa_system_sgpr_workgroup_id_x 1
.end_amdhsa_kernel
```
